```python
import torch

def _softmax(x, axis=-1):
    return torch.softmax(x, dim=axis)
def _gelu(x):
    return torch.nn.functional.gelu(x, approximate="tanh")
def _silu(x):
    return torch.nn.functional.silu(x)
def _sigmoid(x):
    return torch.sigmoid(x)
def _layernorm(x, axis=-1, eps=1e-5):
    m = x.mean(dim=axis, keepdim=True)
    v = x.var(dim=axis, keepdim=True, unbiased=False)
    return (x - m) / torch.sqrt(v + eps)
def _scatter_add(tgt, idx, src, axis=0):
    return tgt.clone().index_add_(axis, idx, src)
def _segment_sum(src, seg, n):
    out = torch.zeros((n,) + src.shape[1:], dtype=src.dtype)
    return out.index_add_(0, seg, src)
def _pad(x, pw):
    flat = tuple(v for pair in reversed(pw) for v in pair)
    return torch.nn.functional.pad(x, flat)

kernel_name = 'standalone__paged_block_table_kv_pagedattention__sampling'

def setup_inputs():

    _w = (lambda a: (lambda t: t.to(torch.bfloat16) if t.is_floating_point() else t)(torch.as_tensor(a)))
    B, Hq, Hkv, Sq, Skv, D = 8, 32, 8, 8, 2048, 128
    bs = 16
    nbps = max(1, Skv // bs)
    num_phys = B * nbps + 4
    bt = torch.randperm(num_phys)[: B * nbps].reshape(B, nbps).to(torch.int64)
    cl = (nbps * bs - (torch.arange(1, B + 1, dtype=torch.int64) * 2654435761) % max(1, nbps * bs // 2)).to(torch.int64)
    return {
        "q": _w((lambda *s: torch.randn(*s, dtype=torch.bfloat16) * 0.8)(B, Hq, Sq, D)),
        "k_cache": _w((lambda *s: torch.randn(*s, dtype=torch.bfloat16) * 0.8)(num_phys, bs, Hkv, D)),
        "v_cache": _w((lambda *s: torch.randn(*s, dtype=torch.bfloat16) * 0.05)(num_phys, bs, Hkv, D)),
        "block_table": _w(bt),
        "context_lens": _w(cl),
    }

def reference(q, k_cache, v_cache, block_table, context_lens):
    B, Hq, Sq, D = q.shape
    bs = k_cache.shape[1]
    Hkv = k_cache.shape[2]
    nbps = block_table.shape[1]
    Skv = nbps * bs
    bt = block_table.reshape(-1)
    k = (lambda x, *d: x.permute(*d))(k_cache[bt].reshape(B, Skv, Hkv, D), 0, 2, 1, 3)
    v = (lambda x, *d: x.permute(*d))(v_cache[bt].reshape(B, Skv, Hkv, D), 0, 2, 1, 3)
    g = Hq // Hkv
    qg = q.reshape(B, Hkv, g, Sq, D)
    scores = torch.einsum("bhgqd,bhkd->bhgqk", qg, k) * (D ** -0.5)
    pos = torch.arange(Skv)
    msk = pos[None, :] < context_lens[:, None]
    scores = torch.where(msk[:, None, None, None, :], scores, -1e9)
    p = _softmax(scores, axis=-1)
    out = torch.einsum("bhgqk,bhkd->bhgqd", p, v)
    return out.reshape(B, Hq, Sq, D)
```

```asm
; @launch grid=(256,1,1) block=(256,1,1) lds=159808
.amdgcn_target "amdgcn-amd-amdhsa--gfx950"
.text
.globl standalone__paged_block_table_kv_pagedattention__sampling_kernel
.p2align 8
.type standalone__paged_block_table_kv_pagedattention__sampling_kernel,@function
standalone__paged_block_table_kv_pagedattention__sampling_kernel:
    s_load_dwordx16 s[4:19], s[0:1], 0
    s_cmp_ge_u32 s2, 256
    s_cbranch_scc1 L_end
    s_getpc_b64 s[98:99]
L_pc0:
    v_lshrrev_b32 v62, 6, v0
    v_and_b32 v61, 3, v0
    v_lshl_add_u32 v62, v62, 2, v61
    v_lshlrev_b32 v62, 7, v62
    global_load_dword v58, v62, s[98:99]
    v_and_b32 v1, 63, v0
    v_lshrrev_b32 v21, 6, v0
    v_min_u32 v26, 7, v1
    v_readfirstlane_b32 s20, v21
    v_lshlrev_b32 v26, 2, v26
    v_lshlrev_b32 v27, 6, v1
    s_and_b32 s21, s2, 7
    s_lshl_b32 s21, s21, 2
    s_lshr_b32 s21, 0x76432501, s21
    s_and_b32 s21, s21, 7
    s_lshr_b32 s22, s2, 3
    s_lshl_b32 s30, s21, 5
    s_add_u32 s31, s30, s22
    s_lshl_b32 s94, s31, 14
    s_lshl_b32 s31, s20, 12
    s_add_u32 s94, s94, s31
    v_add_u32 v28, s94, v27
    v_lshlrev_b32 v29, 5, v26
    s_lshl_b32 s31, s20, 10
    v_add_u32 v29, s31, v29
    s_waitcnt lgkmcnt(0)
    s_load_dwordx8 s[40:47], s[12:13], 0
    global_load_dword v59, v29, s[10:11]
    global_load_dword v57, v28, s[18:19]
    v_and_b32 v56, 15, v1
    s_lshl_b32 s31, s20, 4
    v_add_u32 v56, s31, v56
    v_lshlrev_b32 v56, 7, v56
    v_add_u32 v56, 2048, v56
    v_min_u32 v56, L_end-L_pc0, v56
    global_load_dword v58, v56, s[98:99]
    v_and_b32 v3, 15, v1
    v_add_u32 v21, 1, v1
    v_cvt_f32_u32 v21, v21
    v_rcp_f32 v21, v21
    v_lshrrev_b32 v2, 4, v1
    v_mul_f32 v21, 0x47800000, v21
    v_cvt_u32_f32 v21, v21
    v_add_u32 v22, 1, v21
    v_add_u32 v27, 0, v2
    v_xor_b32 v28, v27, v3
    v_lshlrev_b32 v29, 11, v27
    v_lshl_add_u32 v4, v28, 4, v29
    v_add_u32 v27, 4, v2
    v_xor_b32 v28, v27, v3
    v_lshlrev_b32 v29, 11, v27
    v_subrev_u32 v29, 1024, v29
    v_lshl_add_u32 v5, v28, 4, v29
    v_add_u32 v27, 8, v2
    v_xor_b32 v28, v27, v3
    v_lshlrev_b32 v29, 11, v27
    v_subrev_u32 v29, 2048, v29
    v_lshl_add_u32 v6, v28, 4, v29
    v_add_u32 v27, 12, v2
    v_xor_b32 v28, v27, v3
    v_lshlrev_b32 v29, 11, v27
    v_subrev_u32 v29, 3072, v29
    v_lshl_add_u32 v7, v28, 4, v29
    s_mul_i32 s38, s20, 28672
    s_lshl_b32 s30, s21, 8
    s_add_u32 s56, s6, s30
    s_addc_u32 s57, s7, 0
    s_sub_u32 s58, 33685504, s30
    s_mov_b32 s59, 0x20000
    s_add_u32 s60, s8, s30
    s_addc_u32 s61, s9, 0
    s_sub_u32 s62, 33685504, s30
    s_mov_b32 s63, 0x20000
    s_mov_b32 s84, s10
    s_mov_b32 s85, s11
    s_mov_b32 s86, 4096
    s_mov_b32 s87, 0x20000
    s_lshl_b32 s31, s20, 3
    v_add_u32 v27, s31, v2
    v_and_b32 v21, 15, v27
    v_xor_b32 v21, v21, v3
    v_lshlrev_b32 v27, 8, v27
    v_lshl_add_u32 v28, v21, 4, v27
    v_add_u32 v27, s31, v2
    v_add_u32 v27, 4, v27
    v_and_b32 v21, 15, v27
    v_xor_b32 v21, v21, v3
    v_lshlrev_b32 v27, 8, v27
    v_subrev_u32 v27, 1024, v27
    v_lshl_add_u32 v29, v21, 4, v27
    s_waitcnt lgkmcnt(0)
    v_writelane_b32 v23, s40, 0
    v_writelane_b32 v23, s41, 1
    v_writelane_b32 v23, s42, 2
    v_writelane_b32 v23, s43, 3
    v_writelane_b32 v23, s44, 4
    v_writelane_b32 v23, s45, 5
    v_writelane_b32 v23, s46, 6
    v_writelane_b32 v23, s47, 7
    v_add_u32 v25, -1, v23
    v_min_u32 v25, 0x7ff, v25
    v_lshrrev_b32 v24, 4, v25
    s_nop 0
    v_readlane_b32 s40, v24, 0
    v_readlane_b32 s41, v24, 1
    v_readlane_b32 s42, v24, 2
    v_readlane_b32 s43, v24, 3
    v_readlane_b32 s44, v24, 4
    v_readlane_b32 s45, v24, 5
    v_readlane_b32 s46, v24, 6
    v_readlane_b32 s47, v24, 7
    v_mul_u32_u24 v26, s40, v22
    v_lshrrev_b32 v26, 16, v26
    v_mul_u32_u24 v27, s41, v22
    v_add_u32_sdwa v26, v26, v27 dst_sel:DWORD dst_unused:UNUSED_PAD src0_sel:DWORD src1_sel:WORD_1
    v_mul_u32_u24 v27, s42, v22
    v_add_u32_sdwa v26, v26, v27 dst_sel:DWORD dst_unused:UNUSED_PAD src0_sel:DWORD src1_sel:WORD_1
    v_mul_u32_u24 v27, s43, v22
    v_add_u32_sdwa v26, v26, v27 dst_sel:DWORD dst_unused:UNUSED_PAD src0_sel:DWORD src1_sel:WORD_1
    v_mul_u32_u24 v27, s44, v22
    v_add_u32_sdwa v26, v26, v27 dst_sel:DWORD dst_unused:UNUSED_PAD src0_sel:DWORD src1_sel:WORD_1
    v_mul_u32_u24 v27, s45, v22
    v_add_u32_sdwa v26, v26, v27 dst_sel:DWORD dst_unused:UNUSED_PAD src0_sel:DWORD src1_sel:WORD_1
    v_mul_u32_u24 v27, s46, v22
    v_add_u32_sdwa v26, v26, v27 dst_sel:DWORD dst_unused:UNUSED_PAD src0_sel:DWORD src1_sel:WORD_1
    v_mul_u32_u24 v27, s47, v22
    v_add_u32_sdwa v26, v26, v27 dst_sel:DWORD dst_unused:UNUSED_PAD src0_sel:DWORD src1_sel:WORD_1
    v_cmp_ge_u32 vcc, 24, v26
    s_nop 1
    s_ff1_i32_b64 s30, vcc
    s_nop 0
    v_readlane_b32 s31, v22, s30
    s_nop 1
    v_mul_u32_u24 v26, s31, v24
    v_lshrrev_b32 v26, 16, v26
    v_add_u32 v26, 1, v26
    v_mov_b32 v27, v26
    s_nop 1
    v_add_u32_dpp v27, v27, v27 row_shr:1 row_mask:0xf bank_mask:0xf bound_ctrl:0
    s_nop 1
    v_add_u32_dpp v27, v27, v27 row_shr:2 row_mask:0xf bank_mask:0xf bound_ctrl:0
    s_nop 1
    v_add_u32_dpp v27, v27, v27 row_shr:4 row_mask:0xf bank_mask:0xf bound_ctrl:0
    v_cmp_lt_u32 vcc, s22, v27
    s_nop 1
    s_and_b32 vcc_lo, vcc_lo, 0xff
    s_cbranch_scc0 L_end
    s_ff1_i32_b32 s23, vcc_lo
    s_nop 0
    v_readlane_b32 s24, v26, s23
    v_readlane_b32 s25, v27, s23
    v_readlane_b32 s32, v24, s23
    v_readlane_b32 s27, v25, s23
    v_readlane_b32 s34, v23, s23
    s_sub_u32 s30, s24, 1
    v_readlane_b32 s31, v22, s30
    s_sub_u32 s25, s25, s24
    s_sub_u32 s26, s22, s25
    s_add_u32 s32, s32, 1
    s_mul_i32 s31, s31, s32
    s_mul_i32 s33, s31, s26
    s_add_u32 s31, s31, s33
    s_lshr_b32 s33, s33, 16
    s_lshr_b32 s31, s31, 16
    s_cmp_eq_u32 s26, s30
    s_cselect_b32 s31, s32, s31
    s_sub_u32 s31, s31, s33
    s_add_u32 s36, s31, 7
    s_lshr_b32 s36, s36, 3
    s_lshr_b32 s30, s31, 2
    s_and_b32 s31, s31, 3
    s_mov_b32 s70, s30
    s_mov_b32 s71, s31
    s_mul_i32 s32, s20, s30
    s_add_u32 s33, s33, s32
    s_min_u32 s32, s20, s31
    s_add_u32 s33, s33, s32
    s_cmp_lt_u32 s20, s31
    s_addc_u32 s28, s30, 0
    s_lshl_b32 s30, s23, 7
    s_add_u32 s30, s30, s33
    s_lshl_b32 s30, s30, 2
    s_buffer_load_dwordx8 s[40:47], s[84:87], s30
    s_add_u32 s27, s27, 1
    s_lshl_b32 s33, s33, 4
    s_sub_i32 s29, s27, s33
    s_lshl_b32 s32, s28, 4
    s_min_i32 s29, s29, s32
    s_lshl_b32 s30, s23, 16
    s_lshl_b32 s31, s21, 13
    s_add_u32 s30, s30, s31
    s_add_u32 s64, s4, s30
    s_addc_u32 s65, s5, 0
    s_mov_b32 s66, 8192
    s_mov_b32 s67, 0x20000
    s_add_u32 s72, s14, s30
    s_addc_u32 s73, s15, 0
    s_mov_b32 s74, 8192
    s_mov_b32 s75, 0x20000
    s_waitcnt lgkmcnt(0)
    s_add_u32 m0, s38, 0
    s_lshl_b32 s52, s44, 15
    s_cmp_gt_u32 s28, 4
    s_cselect_b32 s52, s52, 0x80000000
    buffer_load_dwordx4 v4, s[56:59], s52 offen offset:0 nt lds
    buffer_load_dwordx4 v5, s[56:59], s52 offen offset:1024 nt lds
    buffer_load_dwordx4 v6, s[56:59], s52 offen offset:2048 nt lds
    buffer_load_dwordx4 v7, s[56:59], s52 offen offset:3072 nt lds
    s_lshl_b32 s31, s20, 11
    s_add_u32 m0, s31, 151616
    s_nop 0
    buffer_load_dwordx4 v28, s[64:67], 0 offen offset:0 lds
    buffer_load_dwordx4 v29, s[64:67], 0 offen offset:1024 lds
    s_add_u32 m0, s38, 4096
    s_lshl_b32 s51, s43, 15
    s_cmp_gt_u32 s28, 3
    s_cselect_b32 s51, s51, 0x80000000
    buffer_load_dwordx4 v4, s[56:59], s51 offen offset:0 nt lds
    buffer_load_dwordx4 v5, s[56:59], s51 offen offset:1024 nt lds
    buffer_load_dwordx4 v6, s[56:59], s51 offen offset:2048 nt lds
    buffer_load_dwordx4 v7, s[56:59], s51 offen offset:3072 nt lds
    s_add_u32 m0, s38, 8192
    s_lshl_b32 s53, s45, 15
    s_cmp_gt_u32 s28, 5
    s_cselect_b32 s53, s53, 0x80000000
    buffer_load_dwordx4 v4, s[56:59], s53 offen offset:0 nt lds
    buffer_load_dwordx4 v5, s[56:59], s53 offen offset:1024 nt lds
    buffer_load_dwordx4 v6, s[56:59], s53 offen offset:2048 nt lds
    buffer_load_dwordx4 v7, s[56:59], s53 offen offset:3072 nt lds
    s_add_u32 m0, s38, 12288
    s_lshl_b32 s54, s46, 15
    s_cmp_gt_u32 s28, 6
    s_cselect_b32 s54, s54, 0x80000000
    buffer_load_dwordx4 v4, s[56:59], s54 offen offset:0 nt lds
    buffer_load_dwordx4 v5, s[56:59], s54 offen offset:1024 nt lds
    buffer_load_dwordx4 v6, s[56:59], s54 offen offset:2048 nt lds
    buffer_load_dwordx4 v7, s[56:59], s54 offen offset:3072 nt lds
    s_add_u32 m0, s38, 16384
    s_lshl_b32 s50, s42, 15
    s_cmp_gt_u32 s28, 2
    s_cselect_b32 s50, s50, 0x80000000
    buffer_load_dwordx4 v4, s[56:59], s50 offen offset:0 nt lds
    buffer_load_dwordx4 v5, s[56:59], s50 offen offset:1024 nt lds
    buffer_load_dwordx4 v6, s[56:59], s50 offen offset:2048 nt lds
    buffer_load_dwordx4 v7, s[56:59], s50 offen offset:3072 nt lds
    s_memrealtime s[96:97]
    s_lshl_b32 s92, s23, 3
    s_add_u32 s92, s92, s21
    s_lshl_b32 s30, s92, 2
    s_cmp_eq_u32 s20, 0
    s_cselect_b32 s30, s30, 0x1000
    s_mov_b32 s76, s16
    s_mov_b32 s77, s17
    s_mov_b32 s78, 256
    s_mov_b32 s79, 0x20000
    v_mov_b32 v62, s30
    v_mov_b32 v61, 0
    s_waitcnt lgkmcnt(0)
    s_and_b32 s93, s96, 0xffffffe0
    s_or_b32 s93, s93, 0x10
    v_mov_b32 v60, s93
    s_mov_b64 exec, 1
    buffer_atomic_cmpswap v[60:61], v62, s[76:79], 0 offen sc0 sc1
    s_mov_b64 exec, -1
    s_mov_b32 s80, s18
    s_mov_b32 s81, s19
    s_mov_b32 s82, 0x10000000
    s_mov_b32 s83, 0x20000
    v_lshlrev_b32 v43, 4, v1
    v_add_u32 v21, 0, v2
    v_lshlrev_b32 v23, 11, v21
    v_and_b32 v21, 7, v21
    v_lshlrev_b32 v21, 1, v21
    v_xor_b32 v22, v21, v3
    v_lshl_add_u32 v8, v22, 4, v23
    v_add_u32 v21, 4, v2
    v_lshlrev_b32 v23, 11, v21
    v_subrev_u32 v23, 1024, v23
    v_and_b32 v21, 7, v21
    v_lshlrev_b32 v21, 1, v21
    v_xor_b32 v22, v21, v3
    v_lshl_add_u32 v9, v22, 4, v23
    v_add_u32 v21, 8, v2
    v_lshlrev_b32 v23, 11, v21
    v_subrev_u32 v23, 2048, v23
    v_and_b32 v21, 7, v21
    v_lshlrev_b32 v21, 1, v21
    v_xor_b32 v22, v21, v3
    v_lshl_add_u32 v10, v22, 4, v23
    v_add_u32 v21, 12, v2
    v_lshlrev_b32 v23, 11, v21
    v_subrev_u32 v23, 3072, v23
    v_and_b32 v21, 7, v21
    v_lshlrev_b32 v21, 1, v21
    v_xor_b32 v22, v21, v3
    v_lshl_add_u32 v11, v22, 4, v23
    v_lshlrev_b32 v21, 8, v3
    v_add_u32 v21, s38, v21
    v_add_u32 v22, 0, v2
    v_xor_b32 v22, v22, v3
    v_lshl_add_u32 v12, v22, 4, v21
    v_add_u32 v22, 4, v2
    v_xor_b32 v22, v22, v3
    v_lshl_add_u32 v13, v22, 4, v21
    v_add_u32 v22, 8, v2
    v_xor_b32 v22, v22, v3
    v_lshl_add_u32 v14, v22, 4, v21
    v_add_u32 v22, 12, v2
    v_xor_b32 v22, v22, v3
    v_lshl_add_u32 v15, v22, 4, v21
    v_lshl_add_u32 v16, v2, 2, 0
    v_lshl_add_u32 v17, v2, 2, 1
    v_lshl_add_u32 v18, v2, 2, 2
    v_lshl_add_u32 v19, v2, 2, 3
    v_mov_b32 v20, 0xf149f2ca
    s_mov_b32 s35, 0x3e0293ee
    v_lshrrev_b32 v21, 2, v1
    v_and_b32 v22, 7, v21
    v_lshlrev_b32 v22, 1, v22
    v_bfe_u32 v23, v1, 1, 1
    s_lshl_b32 s30, s20, 2
    v_add_u32 v23, s30, v23
    v_and_b32 v24, 1, v1
    v_lshlrev_b32 v24, 3, v24
    v_lshl_add_u32 v24, v21, 8, v24
    v_add_u32 v25, 0, v23
    v_xor_b32 v25, v25, v22
    v_lshl_add_u32 v36, v25, 4, v24
    v_add_u32 v38, 57344, v36
    v_add_u32 v25, 2, v23
    v_xor_b32 v25, v25, v22
    v_lshl_add_u32 v37, v25, 4, v24
    v_add_u32 v39, 57344, v37
    v_add_u32 v40, 114688, v43
    s_lshl_b32 s30, s20, 2
    s_add_u32 s30, s30, 147456
    v_add_u32 v41, s30, v43
    v_add_u32 v42, 147456, v43
    v_mov_b32 v21, 0x3f803f80
    v_accvgpr_write_b32 a64, v21
    v_accvgpr_write_b32 a65, v21
    v_accvgpr_write_b32 a66, v21
    v_accvgpr_write_b32 a67, v21
    s_sub_u32 s30, 151616, s38
    v_add_u32 v21, s30, v12
    v_add_u32 v22, s30, v13
    v_add_u32 v23, s30, v14
    v_add_u32 v24, s30, v15
    s_waitcnt vmcnt(17)
    s_barrier
    ds_read_b128 a[0:3], v21 offset:0
    ds_read_b128 a[4:7], v22 offset:0
    ds_read_b128 a[8:11], v23 offset:0
    ds_read_b128 a[12:15], v24 offset:0
    ds_read_b128 a[16:19], v21 offset:4096
    ds_read_b128 a[20:23], v22 offset:4096
    ds_read_b128 a[24:27], v23 offset:4096
    ds_read_b128 a[28:31], v24 offset:4096
    ds_read_b128 a[32:35], v12 offset:0
    ds_read_b128 a[36:39], v13 offset:0
    ds_read_b128 a[40:43], v14 offset:0
    ds_read_b128 a[44:47], v15 offset:0
    s_sub_i32 s30, s29, 64
    v_cmp_gt_i32 s[84:85], s30, v16
    v_cmp_gt_i32 s[86:87], s30, v17
    v_cmp_gt_i32 s[88:89], s30, v18
    v_cmp_gt_i32 s[90:91], s30, v19
    v_cndmask_b32 v32, v20, 0, s[84:85]
    v_cndmask_b32 v33, v20, 0, s[86:87]
    v_cndmask_b32 v34, v20, 0, s[88:89]
    v_cndmask_b32 v35, v20, 0, s[90:91]
    s_waitcnt lgkmcnt(4)
    s_cmp_gt_i32 s34, 0
    s_cbranch_scc1 L_qok
    v_mov_b32 v21, 0
    v_accvgpr_write_b32 a0, v21
    v_accvgpr_write_b32 a1, v21
    v_accvgpr_write_b32 a2, v21
    v_accvgpr_write_b32 a3, v21
    v_accvgpr_write_b32 a4, v21
    v_accvgpr_write_b32 a5, v21
    v_accvgpr_write_b32 a6, v21
    v_accvgpr_write_b32 a7, v21
    v_accvgpr_write_b32 a8, v21
    v_accvgpr_write_b32 a9, v21
    v_accvgpr_write_b32 a10, v21
    v_accvgpr_write_b32 a11, v21
    v_accvgpr_write_b32 a12, v21
    v_accvgpr_write_b32 a13, v21
    v_accvgpr_write_b32 a14, v21
    v_accvgpr_write_b32 a15, v21
    v_accvgpr_write_b32 a16, v21
    v_accvgpr_write_b32 a17, v21
    v_accvgpr_write_b32 a18, v21
    v_accvgpr_write_b32 a19, v21
    v_accvgpr_write_b32 a20, v21
    v_accvgpr_write_b32 a21, v21
    v_accvgpr_write_b32 a22, v21
    v_accvgpr_write_b32 a23, v21
    v_accvgpr_write_b32 a24, v21
    v_accvgpr_write_b32 a25, v21
    v_accvgpr_write_b32 a26, v21
    v_accvgpr_write_b32 a27, v21
    v_accvgpr_write_b32 a28, v21
    v_accvgpr_write_b32 a29, v21
    v_accvgpr_write_b32 a30, v21
    v_accvgpr_write_b32 a31, v21
L_qok:
    s_nop 0
    s_waitcnt lgkmcnt(3)
    v_mfma_f32_16x16x32_bf16 v[96:99], a[32:35], a[0:3], v[32:35]
    v_mfma_f32_16x16x32_bf16 v[100:103], a[32:35], a[16:19], v[32:35]
    s_waitcnt lgkmcnt(2)
    v_mfma_f32_16x16x32_bf16 v[96:99], a[36:39], a[4:7], v[96:99]
    v_mfma_f32_16x16x32_bf16 v[100:103], a[36:39], a[20:23], v[100:103]
    s_waitcnt lgkmcnt(1)
    v_mfma_f32_16x16x32_bf16 v[96:99], a[40:43], a[8:11], v[96:99]
    v_mfma_f32_16x16x32_bf16 v[100:103], a[40:43], a[24:27], v[100:103]
    s_waitcnt lgkmcnt(0)
    v_mfma_f32_16x16x32_bf16 v[96:99], a[44:47], a[12:15], v[96:99]
    v_mfma_f32_16x16x32_bf16 v[100:103], a[44:47], a[28:31], v[100:103]
    s_add_u32 m0, s38, 20480
    s_lshl_b32 s55, s47, 15
    s_cmp_gt_u32 s28, 7
    s_cselect_b32 s55, s55, 0x80000000
    buffer_load_dwordx4 v4, s[56:59], s55 offen offset:0 nt lds
    buffer_load_dwordx4 v5, s[56:59], s55 offen offset:1024 nt lds
    buffer_load_dwordx4 v6, s[56:59], s55 offen offset:2048 nt lds
    buffer_load_dwordx4 v7, s[56:59], s55 offen offset:3072 nt lds
    s_waitcnt vmcnt(17)
    ds_read_b128 a[48:51], v12 offset:4096
    ds_read_b128 a[52:55], v13 offset:4096
    ds_read_b128 a[56:59], v14 offset:4096
    ds_read_b128 a[60:63], v15 offset:4096
    s_sub_i32 s30, s29, 48
    v_cmp_gt_i32 s[84:85], s30, v16
    v_cmp_gt_i32 s[86:87], s30, v17
    v_cmp_gt_i32 s[88:89], s30, v18
    v_cmp_gt_i32 s[90:91], s30, v19
    v_cndmask_b32 v32, v20, 0, s[84:85]
    v_cndmask_b32 v33, v20, 0, s[86:87]
    v_cndmask_b32 v34, v20, 0, s[88:89]
    v_cndmask_b32 v35, v20, 0, s[90:91]
    s_nop 0
    s_waitcnt lgkmcnt(3)
    v_mfma_f32_16x16x32_bf16 v[88:91], a[48:51], a[0:3], v[32:35]
    v_mfma_f32_16x16x32_bf16 v[92:95], a[48:51], a[16:19], v[32:35]
    s_waitcnt lgkmcnt(2)
    v_mfma_f32_16x16x32_bf16 v[88:91], a[52:55], a[4:7], v[88:91]
    v_mfma_f32_16x16x32_bf16 v[92:95], a[52:55], a[20:23], v[92:95]
    s_waitcnt lgkmcnt(1)
    v_mfma_f32_16x16x32_bf16 v[88:91], a[56:59], a[8:11], v[88:91]
    v_mfma_f32_16x16x32_bf16 v[92:95], a[56:59], a[24:27], v[92:95]
    s_waitcnt lgkmcnt(0)
    v_mfma_f32_16x16x32_bf16 v[88:91], a[60:63], a[12:15], v[88:91]
    v_mfma_f32_16x16x32_bf16 v[92:95], a[60:63], a[28:31], v[92:95]
    s_add_u32 m0, s38, 24576
    s_lshl_b32 s49, s41, 15
    s_cmp_gt_u32 s28, 1
    s_cselect_b32 s49, s49, 0x80000000
    buffer_load_dwordx4 v4, s[56:59], s49 offen offset:0 nt lds
    buffer_load_dwordx4 v5, s[56:59], s49 offen offset:1024 nt lds
    buffer_load_dwordx4 v6, s[56:59], s49 offen offset:2048 nt lds
    buffer_load_dwordx4 v7, s[56:59], s49 offen offset:3072 nt lds
    s_waitcnt vmcnt(17)
    ds_read_b128 a[32:35], v12 offset:8192
    ds_read_b128 a[36:39], v13 offset:8192
    ds_read_b128 a[40:43], v14 offset:8192
    ds_read_b128 a[44:47], v15 offset:8192
    s_sub_i32 s30, s29, 80
    v_cmp_gt_i32 s[84:85], s30, v16
    v_cmp_gt_i32 s[86:87], s30, v17
    v_cmp_gt_i32 s[88:89], s30, v18
    v_cmp_gt_i32 s[90:91], s30, v19
    v_cndmask_b32 v32, v20, 0, s[84:85]
    v_cndmask_b32 v33, v20, 0, s[86:87]
    v_cndmask_b32 v34, v20, 0, s[88:89]
    v_cndmask_b32 v35, v20, 0, s[90:91]
    s_nop 0
    s_waitcnt lgkmcnt(3)
    v_mfma_f32_16x16x32_bf16 v[104:107], a[32:35], a[0:3], v[32:35]
    v_mfma_f32_16x16x32_bf16 v[108:111], a[32:35], a[16:19], v[32:35]
    s_waitcnt lgkmcnt(2)
    v_mfma_f32_16x16x32_bf16 v[104:107], a[36:39], a[4:7], v[104:107]
    v_mfma_f32_16x16x32_bf16 v[108:111], a[36:39], a[20:23], v[108:111]
    s_waitcnt lgkmcnt(1)
    v_mfma_f32_16x16x32_bf16 v[104:107], a[40:43], a[8:11], v[104:107]
    v_mfma_f32_16x16x32_bf16 v[108:111], a[40:43], a[24:27], v[108:111]
    s_waitcnt lgkmcnt(0)
    v_mfma_f32_16x16x32_bf16 v[104:107], a[44:47], a[12:15], v[104:107]
    v_mfma_f32_16x16x32_bf16 v[108:111], a[44:47], a[28:31], v[108:111]
    s_add_u32 m0, s38, 0
    s_lshl_b32 s48, s40, 15
    s_cmp_gt_u32 s28, 0
    s_cselect_b32 s48, s48, 0x80000000
    buffer_load_dwordx4 v4, s[56:59], s48 offen offset:0 nt lds
    buffer_load_dwordx4 v5, s[56:59], s48 offen offset:1024 nt lds
    buffer_load_dwordx4 v6, s[56:59], s48 offen offset:2048 nt lds
    buffer_load_dwordx4 v7, s[56:59], s48 offen offset:3072 nt lds
    s_waitcnt vmcnt(17)
    ds_read_b128 a[48:51], v12 offset:12288
    ds_read_b128 a[52:55], v13 offset:12288
    ds_read_b128 a[56:59], v14 offset:12288
    ds_read_b128 a[60:63], v15 offset:12288
    s_sub_i32 s30, s29, 96
    v_cmp_gt_i32 s[84:85], s30, v16
    v_cmp_gt_i32 s[86:87], s30, v17
    v_cmp_gt_i32 s[88:89], s30, v18
    v_cmp_gt_i32 s[90:91], s30, v19
    v_cndmask_b32 v32, v20, 0, s[84:85]
    v_cndmask_b32 v33, v20, 0, s[86:87]
    v_cndmask_b32 v34, v20, 0, s[88:89]
    v_cndmask_b32 v35, v20, 0, s[90:91]
    s_nop 0
    s_waitcnt lgkmcnt(3)
    v_mfma_f32_16x16x32_bf16 v[112:115], a[48:51], a[0:3], v[32:35]
    v_mfma_f32_16x16x32_bf16 v[116:119], a[48:51], a[16:19], v[32:35]
    s_waitcnt lgkmcnt(2)
    v_mfma_f32_16x16x32_bf16 v[112:115], a[52:55], a[4:7], v[112:115]
    v_mfma_f32_16x16x32_bf16 v[116:119], a[52:55], a[20:23], v[116:119]
    s_waitcnt lgkmcnt(1)
    v_mfma_f32_16x16x32_bf16 v[112:115], a[56:59], a[8:11], v[112:115]
    v_mfma_f32_16x16x32_bf16 v[116:119], a[56:59], a[24:27], v[116:119]
    s_waitcnt lgkmcnt(0)
    v_mfma_f32_16x16x32_bf16 v[112:115], a[60:63], a[12:15], v[112:115]
    v_mfma_f32_16x16x32_bf16 v[116:119], a[60:63], a[28:31], v[116:119]
    s_add_u32 m0, s38, 4096
    s_nop 0
    buffer_load_dwordx4 v8, s[60:63], s48 offen offset:0 nt lds
    buffer_load_dwordx4 v9, s[60:63], s48 offen offset:1024 nt lds
    buffer_load_dwordx4 v10, s[60:63], s48 offen offset:2048 nt lds
    buffer_load_dwordx4 v11, s[60:63], s48 offen offset:3072 nt lds
    s_waitcnt vmcnt(17)
    ds_read_b128 a[32:35], v12 offset:16384
    ds_read_b128 a[36:39], v13 offset:16384
    ds_read_b128 a[40:43], v14 offset:16384
    ds_read_b128 a[44:47], v15 offset:16384
    s_sub_i32 s30, s29, 32
    v_cmp_gt_i32 s[84:85], s30, v16
    v_cmp_gt_i32 s[86:87], s30, v17
    v_cmp_gt_i32 s[88:89], s30, v18
    v_cmp_gt_i32 s[90:91], s30, v19
    v_cndmask_b32 v32, v20, 0, s[84:85]
    v_cndmask_b32 v33, v20, 0, s[86:87]
    v_cndmask_b32 v34, v20, 0, s[88:89]
    v_cndmask_b32 v35, v20, 0, s[90:91]
    s_nop 0
    s_waitcnt lgkmcnt(3)
    v_mfma_f32_16x16x32_bf16 v[80:83], a[32:35], a[0:3], v[32:35]
    v_mfma_f32_16x16x32_bf16 v[84:87], a[32:35], a[16:19], v[32:35]
    s_waitcnt lgkmcnt(2)
    v_mfma_f32_16x16x32_bf16 v[80:83], a[36:39], a[4:7], v[80:83]
    v_mfma_f32_16x16x32_bf16 v[84:87], a[36:39], a[20:23], v[84:87]
    s_waitcnt lgkmcnt(1)
    v_mfma_f32_16x16x32_bf16 v[80:83], a[40:43], a[8:11], v[80:83]
    v_mfma_f32_16x16x32_bf16 v[84:87], a[40:43], a[24:27], v[84:87]
    s_waitcnt lgkmcnt(0)
    v_mfma_f32_16x16x32_bf16 v[80:83], a[44:47], a[12:15], v[80:83]
    v_mfma_f32_16x16x32_bf16 v[84:87], a[44:47], a[28:31], v[84:87]
    s_add_u32 m0, s38, 8192
    s_nop 0
    buffer_load_dwordx4 v8, s[60:63], s49 offen offset:0 nt lds
    buffer_load_dwordx4 v9, s[60:63], s49 offen offset:1024 nt lds
    buffer_load_dwordx4 v10, s[60:63], s49 offen offset:2048 nt lds
    buffer_load_dwordx4 v11, s[60:63], s49 offen offset:3072 nt lds
    s_waitcnt vmcnt(16)
    ds_read_b128 a[48:51], v12 offset:20480
    ds_read_b128 a[52:55], v13 offset:20480
    ds_read_b128 a[56:59], v14 offset:20480
    ds_read_b128 a[60:63], v15 offset:20480
    s_sub_i32 s30, s29, 112
    v_cmp_gt_i32 s[84:85], s30, v16
    v_cmp_gt_i32 s[86:87], s30, v17
    v_cmp_gt_i32 s[88:89], s30, v18
    v_cmp_gt_i32 s[90:91], s30, v19
    v_cndmask_b32 v32, v20, 0, s[84:85]
    v_cndmask_b32 v33, v20, 0, s[86:87]
    v_cndmask_b32 v34, v20, 0, s[88:89]
    v_cndmask_b32 v35, v20, 0, s[90:91]
    v_readfirstlane_b32 s31, v60
    s_nop 0
    s_waitcnt lgkmcnt(3)
    v_mfma_f32_16x16x32_bf16 v[120:123], a[48:51], a[0:3], v[32:35]
    v_mfma_f32_16x16x32_bf16 v[124:127], a[48:51], a[16:19], v[32:35]
    s_waitcnt lgkmcnt(2)
    v_mfma_f32_16x16x32_bf16 v[120:123], a[52:55], a[4:7], v[120:123]
    v_mfma_f32_16x16x32_bf16 v[124:127], a[52:55], a[20:23], v[124:127]
    s_waitcnt lgkmcnt(1)
    v_mfma_f32_16x16x32_bf16 v[120:123], a[56:59], a[8:11], v[120:123]
    v_mfma_f32_16x16x32_bf16 v[124:127], a[56:59], a[24:27], v[124:127]
    s_waitcnt lgkmcnt(0)
    v_mfma_f32_16x16x32_bf16 v[120:123], a[60:63], a[12:15], v[120:123]
    v_mfma_f32_16x16x32_bf16 v[124:127], a[60:63], a[28:31], v[124:127]
    s_cmp_eq_u32 s31, 0
    s_cselect_b32 s93, s93, s31
    s_getreg_b32 s30, hwreg(HW_REG_XCC_ID)
    s_and_b32 s3, s30, 7
    s_or_b32 s30, s93, s3
    s_lshl_b32 s95, s92, 7
    s_add_u32 s95, s95, 6291456
    s_lshl_b32 s31, s26, 2
    s_add_u32 s31, s31, s95
    s_cmp_eq_u32 s20, 0
    s_cselect_b32 s31, s31, 0x80000000
    v_mov_b32 v26, s30
    v_mov_b32 v27, 0
    s_mov_b64 exec, 1
    buffer_store_dword v26, v27, s[80:83], s31 offen sc1
    s_mov_b64 exec, -1
    s_waitcnt vmcnt(13)
    ds_read_b128 a[32:35], v12 offset:24576
    ds_read_b128 a[36:39], v13 offset:24576
    ds_read_b128 a[40:43], v14 offset:24576
    ds_read_b128 a[44:47], v15 offset:24576
    s_sub_i32 s30, s29, 16
    v_cmp_gt_i32 s[84:85], s30, v16
    v_cmp_gt_i32 s[86:87], s30, v17
    v_cmp_gt_i32 s[88:89], s30, v18
    v_cmp_gt_i32 s[90:91], s30, v19
    v_cndmask_b32 v32, v20, 0, s[84:85]
    v_cndmask_b32 v33, v20, 0, s[86:87]
    v_cndmask_b32 v34, v20, 0, s[88:89]
    v_cndmask_b32 v35, v20, 0, s[90:91]
    s_nop 0
    s_waitcnt lgkmcnt(3)
    v_mfma_f32_16x16x32_bf16 v[72:75], a[32:35], a[0:3], v[32:35]
    v_mfma_f32_16x16x32_bf16 v[76:79], a[32:35], a[16:19], v[32:35]
    s_waitcnt lgkmcnt(2)
    v_mfma_f32_16x16x32_bf16 v[72:75], a[36:39], a[4:7], v[72:75]
    v_mfma_f32_16x16x32_bf16 v[76:79], a[36:39], a[20:23], v[76:79]
    s_waitcnt lgkmcnt(1)
    v_mfma_f32_16x16x32_bf16 v[72:75], a[40:43], a[8:11], v[72:75]
    v_mfma_f32_16x16x32_bf16 v[76:79], a[40:43], a[24:27], v[76:79]
    s_waitcnt lgkmcnt(0)
    v_mfma_f32_16x16x32_bf16 v[72:75], a[44:47], a[12:15], v[72:75]
    v_mfma_f32_16x16x32_bf16 v[76:79], a[44:47], a[28:31], v[76:79]
    s_waitcnt vmcnt(9)
    ds_read_b128 a[48:51], v12 offset:0
    ds_read_b128 a[52:55], v13 offset:0
    ds_read_b128 a[56:59], v14 offset:0
    ds_read_b128 a[60:63], v15 offset:0
    s_sub_i32 s30, s29, 0
    v_cmp_gt_i32 s[84:85], s30, v16
    v_cmp_gt_i32 s[86:87], s30, v17
    v_cmp_gt_i32 s[88:89], s30, v18
    v_cmp_gt_i32 s[90:91], s30, v19
    v_cndmask_b32 v32, v20, 0, s[84:85]
    v_cndmask_b32 v33, v20, 0, s[86:87]
    v_cndmask_b32 v34, v20, 0, s[88:89]
    v_cndmask_b32 v35, v20, 0, s[90:91]
    s_nop 0
    s_waitcnt lgkmcnt(3)
    v_mfma_f32_16x16x32_bf16 v[64:67], a[48:51], a[0:3], v[32:35]
    v_mfma_f32_16x16x32_bf16 v[68:71], a[48:51], a[16:19], v[32:35]
    s_waitcnt lgkmcnt(2)
    v_mfma_f32_16x16x32_bf16 v[64:67], a[52:55], a[4:7], v[64:67]
    v_mfma_f32_16x16x32_bf16 v[68:71], a[52:55], a[20:23], v[68:71]
    s_waitcnt lgkmcnt(1)
    v_mfma_f32_16x16x32_bf16 v[64:67], a[56:59], a[8:11], v[64:67]
    v_mfma_f32_16x16x32_bf16 v[68:71], a[56:59], a[24:27], v[68:71]
    s_waitcnt lgkmcnt(0)
    v_mfma_f32_16x16x32_bf16 v[64:67], a[60:63], a[12:15], v[64:67]
    v_mfma_f32_16x16x32_bf16 v[68:71], a[60:63], a[28:31], v[68:71]
    v_max3_f32 v30, v96, v97, v98
    v_max3_f32 v30, v30, v99, v88
    v_max3_f32 v30, v30, v89, v90
    v_max3_f32 v30, v30, v91, v104
    v_max3_f32 v30, v30, v105, v106
    v_max3_f32 v30, v30, v107, v112
    v_max3_f32 v30, v30, v113, v114
    v_max3_f32 v30, v30, v115, v80
    v_max3_f32 v30, v30, v81, v82
    v_max3_f32 v30, v30, v83, v120
    v_max3_f32 v30, v30, v121, v122
    v_max3_f32 v30, v30, v123, v72
    v_max3_f32 v30, v30, v73, v74
    v_max3_f32 v30, v30, v75, v64
    v_max3_f32 v30, v30, v65, v66
    v_max_f32 v30, v30, v67
    v_max3_f32 v31, v100, v101, v102
    v_max3_f32 v31, v31, v103, v92
    v_max3_f32 v31, v31, v93, v94
    v_max3_f32 v31, v31, v95, v108
    v_max3_f32 v31, v31, v109, v110
    v_max3_f32 v31, v31, v111, v116
    v_max3_f32 v31, v31, v117, v118
    v_max3_f32 v31, v31, v119, v84
    v_max3_f32 v31, v31, v85, v86
    v_max3_f32 v31, v31, v87, v124
    v_max3_f32 v31, v31, v125, v126
    v_max3_f32 v31, v31, v127, v76
    v_max3_f32 v31, v31, v77, v78
    v_max3_f32 v31, v31, v79, v68
    v_max3_f32 v31, v31, v69, v70
    v_max_f32 v31, v31, v71
    v_mov_b32 v21, v30
    v_mov_b32 v22, v31
    s_nop 1
    v_permlane16_swap_b32 v30, v21
    v_permlane16_swap_b32 v31, v22
    v_max_f32 v30, v30, v21
    v_max_f32 v31, v31, v22
    v_mov_b32 v21, v30
    v_mov_b32 v22, v31
    s_nop 1
    v_permlane32_swap_b32 v30, v21
    v_permlane32_swap_b32 v31, v22
    v_max_f32 v30, v30, v21
    v_max_f32 v31, v31, v22
    ds_write_b32 v41, v30 offset:0
    ds_write_b32 v41, v31 offset:1024
    s_lshl_b32 s30, s20, 2
    s_add_u32 s30, s30, 151552
    v_mov_b32 v23, s30
    v_mov_b32 v24, s93
    s_mov_b64 exec, 1
    ds_write_b32 v23, v24
    s_mov_b64 exec, -1
    s_add_u32 m0, s38, 12288
    s_nop 0
    buffer_load_dwordx4 v8, s[60:63], s50 offen offset:0 nt lds
    buffer_load_dwordx4 v9, s[60:63], s50 offen offset:1024 nt lds
    buffer_load_dwordx4 v10, s[60:63], s50 offen offset:2048 nt lds
    buffer_load_dwordx4 v11, s[60:63], s50 offen offset:3072 nt lds
    s_waitcnt lgkmcnt(0)
    s_barrier
    ds_read_b128 v[144:147], v42 offset:0
    ds_read_b128 v[148:151], v42 offset:1024
    v_mov_b32 v23, 151552
    ds_read_b32 v24, v23
    s_waitcnt lgkmcnt(1)
    v_max3_f32 v30, v144, v145, v146
    v_max3_f32 v31, v148, v149, v150
    v_max_f32 v30, v30, v147
    v_max_f32 v31, v31, v151
    v_mul_f32 v30, s35, v30
    v_mul_f32 v31, s35, v31
    s_waitcnt lgkmcnt(0)
    v_readfirstlane_b32 s93, v24
    s_lshl_b32 s30, s20, 13
    v_add_u32 v25, s30, v40
    v_fma_f32 v64, v64, s35, -v30
    v_fma_f32 v65, v65, s35, -v30
    v_fma_f32 v66, v66, s35, -v30
    v_fma_f32 v67, v67, s35, -v30
    v_exp_f32 v64, v64
    v_exp_f32 v65, v65
    v_exp_f32 v66, v66
    v_exp_f32 v67, v67
    v_fma_f32 v72, v72, s35, -v30
    v_fma_f32 v73, v73, s35, -v30
    v_fma_f32 v74, v74, s35, -v30
    v_fma_f32 v75, v75, s35, -v30
    v_exp_f32 v72, v72
    v_exp_f32 v73, v73
    v_exp_f32 v74, v74
    v_exp_f32 v75, v75
    v_cvt_pk_bf16_f32 v64, v64, v65
    v_cvt_pk_bf16_f32 v65, v66, v67
    v_cvt_pk_bf16_f32 v66, v72, v73
    v_cvt_pk_bf16_f32 v67, v74, v75
    ds_write_b128 v25, v[64:67] offset:0
    v_fma_f32 v68, v68, s35, -v31
    v_fma_f32 v69, v69, s35, -v31
    v_fma_f32 v70, v70, s35, -v31
    v_fma_f32 v71, v71, s35, -v31
    v_exp_f32 v68, v68
    v_exp_f32 v69, v69
    v_exp_f32 v70, v70
    v_exp_f32 v71, v71
    v_fma_f32 v76, v76, s35, -v31
    v_fma_f32 v77, v77, s35, -v31
    v_fma_f32 v78, v78, s35, -v31
    v_fma_f32 v79, v79, s35, -v31
    v_exp_f32 v76, v76
    v_exp_f32 v77, v77
    v_exp_f32 v78, v78
    v_exp_f32 v79, v79
    v_cvt_pk_bf16_f32 v68, v68, v69
    v_cvt_pk_bf16_f32 v69, v70, v71
    v_cvt_pk_bf16_f32 v70, v76, v77
    v_cvt_pk_bf16_f32 v71, v78, v79
    ds_write_b128 v25, v[68:71] offset:1024
    v_mfma_f32_16x16x32_bf16 v[52:55], a[64:67], v[64:67], 0
    s_add_u32 m0, s38, 16384
    s_nop 0
    buffer_load_dwordx4 v8, s[60:63], s51 offen offset:0 nt lds
    buffer_load_dwordx4 v9, s[60:63], s51 offen offset:1024 nt lds
    buffer_load_dwordx4 v10, s[60:63], s51 offen offset:2048 nt lds
    buffer_load_dwordx4 v11, s[60:63], s51 offen offset:3072 nt lds
    v_fma_f32 v80, v80, s35, -v30
    v_fma_f32 v81, v81, s35, -v30
    v_fma_f32 v82, v82, s35, -v30
    v_fma_f32 v83, v83, s35, -v30
    v_exp_f32 v80, v80
    v_exp_f32 v81, v81
    v_exp_f32 v82, v82
    v_exp_f32 v83, v83
    v_fma_f32 v88, v88, s35, -v30
    v_fma_f32 v89, v89, s35, -v30
    v_fma_f32 v90, v90, s35, -v30
    v_fma_f32 v91, v91, s35, -v30
    v_exp_f32 v88, v88
    v_exp_f32 v89, v89
    v_exp_f32 v90, v90
    v_exp_f32 v91, v91
    v_cvt_pk_bf16_f32 v80, v80, v81
    v_cvt_pk_bf16_f32 v81, v82, v83
    v_cvt_pk_bf16_f32 v82, v88, v89
    v_cvt_pk_bf16_f32 v83, v90, v91
    ds_write_b128 v25, v[80:83] offset:2048
    v_mfma_f32_16x16x32_bf16 v[56:59], a[64:67], v[68:71], 0
    v_fma_f32 v84, v84, s35, -v31
    v_fma_f32 v85, v85, s35, -v31
    v_fma_f32 v86, v86, s35, -v31
    v_fma_f32 v87, v87, s35, -v31
    v_exp_f32 v84, v84
    v_exp_f32 v85, v85
    v_exp_f32 v86, v86
    v_exp_f32 v87, v87
    v_fma_f32 v92, v92, s35, -v31
    v_fma_f32 v93, v93, s35, -v31
    v_fma_f32 v94, v94, s35, -v31
    v_fma_f32 v95, v95, s35, -v31
    v_exp_f32 v92, v92
    v_exp_f32 v93, v93
    v_exp_f32 v94, v94
    v_exp_f32 v95, v95
    v_cvt_pk_bf16_f32 v84, v84, v85
    v_cvt_pk_bf16_f32 v85, v86, v87
    v_cvt_pk_bf16_f32 v86, v92, v93
    v_cvt_pk_bf16_f32 v87, v94, v95
    ds_write_b128 v25, v[84:87] offset:3072
    v_mfma_f32_16x16x32_bf16 v[52:55], a[64:67], v[80:83], v[52:55]
    s_getpc_b64 s[98:99]
L_tpf:
    v_lshlrev_b32 v21, 7, v1
    v_min_u32 v21, L_end-L_tpf, v21
    global_load_dword v22, v21, s[98:99]
    v_fma_f32 v96, v96, s35, -v30
    v_fma_f32 v97, v97, s35, -v30
    v_fma_f32 v98, v98, s35, -v30
    v_fma_f32 v99, v99, s35, -v30
    v_exp_f32 v96, v96
    v_exp_f32 v97, v97
    v_exp_f32 v98, v98
    v_exp_f32 v99, v99
    v_fma_f32 v104, v104, s35, -v30
    v_fma_f32 v105, v105, s35, -v30
    v_fma_f32 v106, v106, s35, -v30
    v_fma_f32 v107, v107, s35, -v30
    v_exp_f32 v104, v104
    v_exp_f32 v105, v105
    v_exp_f32 v106, v106
    v_exp_f32 v107, v107
    v_cvt_pk_bf16_f32 v96, v96, v97
    v_cvt_pk_bf16_f32 v97, v98, v99
    v_cvt_pk_bf16_f32 v98, v104, v105
    v_cvt_pk_bf16_f32 v99, v106, v107
    ds_write_b128 v25, v[96:99] offset:4096
    v_mfma_f32_16x16x32_bf16 v[56:59], a[64:67], v[84:87], v[56:59]
    v_fma_f32 v100, v100, s35, -v31
    v_fma_f32 v101, v101, s35, -v31
    v_fma_f32 v102, v102, s35, -v31
    v_fma_f32 v103, v103, s35, -v31
    v_exp_f32 v100, v100
    v_exp_f32 v101, v101
    v_exp_f32 v102, v102
    v_exp_f32 v103, v103
    v_fma_f32 v108, v108, s35, -v31
    v_fma_f32 v109, v109, s35, -v31
    v_fma_f32 v110, v110, s35, -v31
    v_fma_f32 v111, v111, s35, -v31
    v_exp_f32 v108, v108
    v_exp_f32 v109, v109
    v_exp_f32 v110, v110
    v_exp_f32 v111, v111
    v_cvt_pk_bf16_f32 v100, v100, v101
    v_cvt_pk_bf16_f32 v101, v102, v103
    v_cvt_pk_bf16_f32 v102, v108, v109
    v_cvt_pk_bf16_f32 v103, v110, v111
    ds_write_b128 v25, v[100:103] offset:5120
    v_mfma_f32_16x16x32_bf16 v[52:55], a[64:67], v[96:99], v[52:55]
    s_add_u32 m0, s38, 20480
    s_nop 0
    buffer_load_dwordx4 v8, s[60:63], s52 offen offset:0 nt lds
    buffer_load_dwordx4 v9, s[60:63], s52 offen offset:1024 nt lds
    buffer_load_dwordx4 v10, s[60:63], s52 offen offset:2048 nt lds
    buffer_load_dwordx4 v11, s[60:63], s52 offen offset:3072 nt lds
    v_fma_f32 v112, v112, s35, -v30
    v_fma_f32 v113, v113, s35, -v30
    v_fma_f32 v114, v114, s35, -v30
    v_fma_f32 v115, v115, s35, -v30
    v_exp_f32 v112, v112
    v_exp_f32 v113, v113
    v_exp_f32 v114, v114
    v_exp_f32 v115, v115
    v_fma_f32 v120, v120, s35, -v30
    v_fma_f32 v121, v121, s35, -v30
    v_fma_f32 v122, v122, s35, -v30
    v_fma_f32 v123, v123, s35, -v30
    v_exp_f32 v120, v120
    v_exp_f32 v121, v121
    v_exp_f32 v122, v122
    v_exp_f32 v123, v123
    v_cvt_pk_bf16_f32 v112, v112, v113
    v_cvt_pk_bf16_f32 v113, v114, v115
    v_cvt_pk_bf16_f32 v114, v120, v121
    v_cvt_pk_bf16_f32 v115, v122, v123
    ds_write_b128 v25, v[112:115] offset:6144
    v_mfma_f32_16x16x32_bf16 v[56:59], a[64:67], v[100:103], v[56:59]
    v_fma_f32 v116, v116, s35, -v31
    v_fma_f32 v117, v117, s35, -v31
    v_fma_f32 v118, v118, s35, -v31
    v_fma_f32 v119, v119, s35, -v31
    v_exp_f32 v116, v116
    v_exp_f32 v117, v117
    v_exp_f32 v118, v118
    v_exp_f32 v119, v119
    v_fma_f32 v124, v124, s35, -v31
    v_fma_f32 v125, v125, s35, -v31
    v_fma_f32 v126, v126, s35, -v31
    v_fma_f32 v127, v127, s35, -v31
    v_exp_f32 v124, v124
    v_exp_f32 v125, v125
    v_exp_f32 v126, v126
    v_exp_f32 v127, v127
    v_cvt_pk_bf16_f32 v116, v116, v117
    v_cvt_pk_bf16_f32 v117, v118, v119
    v_cvt_pk_bf16_f32 v118, v124, v125
    v_cvt_pk_bf16_f32 v119, v126, v127
    ds_write_b128 v25, v[116:119] offset:7168
    v_mfma_f32_16x16x32_bf16 v[52:55], a[64:67], v[112:115], v[52:55]
    s_nop 1
    v_mfma_f32_16x16x32_bf16 v[56:59], a[64:67], v[116:119], v[56:59]
    s_lshl_b32 s30, s21, 5
    s_lshl_b32 s31, s20, 12
    s_nop 2
    s_add_u32 s30, s30, s25
    s_lshl_b32 s92, s30, 14
    s_add_u32 s92, s92, s31
    s_nop 3
    v_add_u32 v25, 2048, v41
    ds_write_b32 v25, v52 offset:0
    ds_write_b32 v25, v56 offset:1024
    s_waitcnt lgkmcnt(0)
    s_barrier
    v_lshlrev_b32 v26, 2, v1
    v_cmp_gt_u32 vcc, s24, v1
    v_mov_b32 v27, 0x40000000
    s_nop 0
    v_cndmask_b32 v26, v27, v26, vcc
    buffer_load_dword v227, v26, s[80:83], s95 offen sc1
    ds_read_b128 v[144:147], v42 offset:2048
    ds_read_b128 v[148:151], v42 offset:3072
    s_mov_b32 s37, 0
    s_lshl_b32 s88, s36, 1
    s_sub_u32 s88, s88, 2
    s_cmp_gt_u32 s70, s88
    s_cselect_b32 s88, 4, s71
    s_mov_b32 s89, 4
    s_mov_b32 s39, 4096
    v_add_u32 v44, 4096, v36
    v_add_u32 v45, 4096, v37
    v_add_u32 v46, 4096, v38
    v_add_u32 v47, 4096, v39
    v_mov_b32 v48, v40
    s_waitcnt lgkmcnt(0)
    v_add_f32 v144, v144, v145
    v_add_f32 v146, v146, v147
    v_add_f32 v148, v148, v149
    v_add_f32 v150, v150, v151
    v_add_f32 v144, v144, v146
    v_add_f32 v148, v148, v150
    v_rcp_f32 v50, v144
    v_log_f32 v145, v144
    v_rcp_f32 v51, v148
    v_log_f32 v149, v148
    s_nop 0
    v_add_f32 v145, v145, v30
    v_add_f32 v149, v149, v31
    v_mov_b32 v210, v145
    v_mov_b32 v214, v149
    v_mov_b32 v218, v145
    v_mov_b32 v222, v149
    v_xor_b32 v224, s93, v145
    v_xor_b32 v225, s93, v149
    v_mov_b32 v128, 0
    v_mov_b32 v129, 0
    v_mov_b32 v130, 0
    v_mov_b32 v131, 0
    v_mov_b32 v132, 0
    v_mov_b32 v133, 0
    v_mov_b32 v134, 0
    v_mov_b32 v135, 0
    v_mov_b32 v136, 0
    v_mov_b32 v137, 0
    v_mov_b32 v138, 0
    v_mov_b32 v139, 0
    v_mov_b32 v140, 0
    v_mov_b32 v141, 0
    v_mov_b32 v142, 0
    v_mov_b32 v143, 0
    v_lshlrev_b32 v226, 8, v3
    v_lshl_add_u32 v226, v2, 3, v226
    s_lshl_b32 s30, s26, 10
    s_add_u32 s40, s30, s92
    s_add_u32 s31, s26, s24
    s_cmp_lt_u32 s31, 4
    s_cselect_b32 s41, 1, 0
    s_lshl_b32 s32, s31, 10
    s_add_u32 s32, s32, s92
    s_sub_u32 s32, s32, 65536
    s_add_u32 s33, s24, 4
    s_cmp_lg_u32 s41, 0
    s_cselect_b32 s32, s32, s40
    s_cselect_b32 s33, s33, s24
    s_mov_b32 s46, s33
    s_add_u32 s30, s40, 0
    s_cmp_gt_u32 s24, 0
    s_cselect_b32 s4, s30, 0x80000000
    s_cselect_b32 s12, s93, 0
    s_add_u32 s30, s40, 16384
    s_cmp_gt_u32 s24, 1
    s_cselect_b32 s5, s30, 0x80000000
    s_cselect_b32 s13, s93, 0
    s_add_u32 s30, s40, 32768
    s_cmp_gt_u32 s24, 2
    s_cselect_b32 s6, s30, 0x80000000
    s_cselect_b32 s14, s93, 0
    s_add_u32 s30, s40, 49152
    s_cmp_gt_u32 s24, 3
    s_cselect_b32 s7, s30, 0x80000000
    s_cselect_b32 s15, s93, 0
    s_add_u32 s30, s32, 65536
    s_cmp_gt_u32 s33, 4
    s_cselect_b32 s8, s30, 0x80000000
    s_cselect_b32 s16, s93, 0
    s_add_u32 s30, s32, 81920
    s_cmp_gt_u32 s33, 5
    s_cselect_b32 s9, s30, 0x80000000
    s_cselect_b32 s17, s93, 0
    s_add_u32 s30, s32, 98304
    s_cmp_gt_u32 s33, 6
    s_cselect_b32 s10, s30, 0x80000000
    s_cselect_b32 s18, s93, 0
    s_add_u32 s30, s32, 114688
    s_cmp_gt_u32 s33, 7
    s_cselect_b32 s11, s30, 0x80000000
    s_cselect_b32 s19, s93, 0
    s_and_b32 s30, s26, 1
    s_lshl_b32 s30, s30, 12
    s_lshr_b32 s42, s26, 1
    s_lshl_b32 s42, s42, 5
    s_add_u32 s42, s42, s30
    s_lshl_b32 s30, s20, 6
    s_add_u32 s42, s42, s30
    s_and_b32 s30, s31, 1
    s_lshl_b32 s30, s30, 12
    s_lshr_b32 s43, s31, 1
    s_lshl_b32 s43, s43, 5
    s_add_u32 s43, s43, s30
    s_lshl_b32 s30, s20, 6
    s_add_u32 s43, s43, s30
    s_mov_b32 s44, s24
    s_min_u32 s45, s24, 8
    v_mov_b32 v66, v20
    v_mov_b32 v70, v20
    v_mov_b32 v74, v20
    v_mov_b32 v78, v20
    v_mov_b32 v82, v20
    v_mov_b32 v86, v20
    v_mov_b32 v90, v20
    v_mov_b32 v94, v20
    s_mov_b32 s47, 0xffff0000
    s_mov_b32 s1, 0
L_round:
    s_add_u32 s30, s37, 1
    s_cmp_eq_u32 s30, s36
    s_cbranch_scc1 L_w0
    s_cmp_eq_u32 s37, 0
    s_cbranch_scc1 L_w20
    s_cmp_eq_u32 s37, 1
    s_cbranch_scc1 L_w12
    s_waitcnt vmcnt(8)
    s_branch L_wd
L_w20:
    s_waitcnt vmcnt(15)
    s_branch L_wd
L_w12:
    s_waitcnt vmcnt(14)
    s_branch L_wd
L_w0:
    s_waitcnt vmcnt(0)
    s_mov_b32 s89, s88
    s_or_b32 s30, s93, s3
    v_cmp_eq_u32 vcc, s30, v227
    s_bfm_b64 s[84:85], s24, 0
    s_nop 0
    s_cmp_eq_u64 vcc, s[84:85]
    s_cselect_b32 s90, 1, 0
L_wd:
    s_barrier
    ds_read_b128 v[144:147], v48 offset:0
    ds_read_b128 v[148:151], v48 offset:1024
    ds_read_b64_tr_b16 v[152:153], v44 offset:0
    ds_read_b64_tr_b16 v[154:155], v44 offset:4096
    ds_read_b64_tr_b16 v[156:157], v45 offset:0
    ds_read_b64_tr_b16 v[158:159], v45 offset:4096
    ds_read_b128 v[160:163], v48 offset:8192
    ds_read_b128 v[164:167], v48 offset:9216
    ds_read_b64_tr_b16 v[168:169], v44 offset:28672
    ds_read_b64_tr_b16 v[170:171], v44 offset:32768
    ds_read_b64_tr_b16 v[172:173], v45 offset:28672
    ds_read_b64_tr_b16 v[174:175], v45 offset:32768
    s_cmp_lg_u32 s37, 0
    s_cbranch_scc1 L_nov5
    s_add_u32 m0, s38, 24576
    s_nop 0
    buffer_load_dwordx4 v8, s[60:63], s53 offen offset:0 nt lds
    buffer_load_dwordx4 v9, s[60:63], s53 offen offset:1024 nt lds
    buffer_load_dwordx4 v10, s[60:63], s53 offen offset:2048 nt lds
    buffer_load_dwordx4 v11, s[60:63], s53 offen offset:3072 nt lds
    s_add_u32 m0, s38, 0
    s_nop 0
    buffer_load_dwordx4 v8, s[60:63], s54 offen offset:0 nt lds
    buffer_load_dwordx4 v9, s[60:63], s54 offen offset:1024 nt lds
    buffer_load_dwordx4 v10, s[60:63], s54 offen offset:2048 nt lds
    buffer_load_dwordx4 v11, s[60:63], s54 offen offset:3072 nt lds
L_nov5:
    s_cmp_lg_u32 s37, 1
    s_cbranch_scc1 L_nov7
    s_add_u32 m0, s38, 4096
    s_nop 0
    buffer_load_dwordx4 v8, s[60:63], s55 offen offset:0 nt lds
    buffer_load_dwordx4 v9, s[60:63], s55 offen offset:1024 nt lds
    buffer_load_dwordx4 v10, s[60:63], s55 offen offset:2048 nt lds
    buffer_load_dwordx4 v11, s[60:63], s55 offen offset:3072 nt lds
L_nov7:
    s_cmp_gt_u32 s89, 2
    s_cbranch_scc1 L_long
    s_waitcnt lgkmcnt(6)
    v_mfma_f32_16x16x32_bf16 v[128:131], v[152:155], v[144:147], v[128:131]
    v_mfma_f32_16x16x32_bf16 v[132:135], v[152:155], v[148:151], v[132:135]
    v_mfma_f32_16x16x32_bf16 v[136:139], v[156:159], v[144:147], v[136:139]
    v_mfma_f32_16x16x32_bf16 v[140:143], v[156:159], v[148:151], v[140:143]
    s_waitcnt lgkmcnt(0)
    v_mfma_f32_16x16x32_bf16 v[128:131], v[168:171], v[160:163], v[128:131]
    v_mfma_f32_16x16x32_bf16 v[132:135], v[168:171], v[164:167], v[132:135]
    v_mfma_f32_16x16x32_bf16 v[136:139], v[172:175], v[160:163], v[136:139]
    v_mfma_f32_16x16x32_bf16 v[140:143], v[172:175], v[164:167], v[140:143]
    s_nop 2
    s_branch L_exit
L_long:
    s_waitcnt lgkmcnt(6)
    ds_read_b128 v[176:179], v48 offset:16384
    ds_read_b128 v[180:183], v48 offset:17408
    ds_read_b64_tr_b16 v[184:185], v46 offset:0
    ds_read_b64_tr_b16 v[186:187], v46 offset:4096
    ds_read_b64_tr_b16 v[188:189], v47 offset:0
    ds_read_b64_tr_b16 v[190:191], v47 offset:4096
    v_mfma_f32_16x16x32_bf16 v[128:131], v[152:155], v[144:147], v[128:131]
    v_mfma_f32_16x16x32_bf16 v[132:135], v[152:155], v[148:151], v[132:135]
    v_mfma_f32_16x16x32_bf16 v[136:139], v[156:159], v[144:147], v[136:139]
    v_mfma_f32_16x16x32_bf16 v[140:143], v[156:159], v[148:151], v[140:143]
    s_waitcnt lgkmcnt(6)
    ds_read_b128 v[192:195], v48 offset:24576
    ds_read_b128 v[196:199], v48 offset:25600
    ds_read_b64_tr_b16 v[200:201], v46 offset:28672
    ds_read_b64_tr_b16 v[202:203], v46 offset:32768
    ds_read_b64_tr_b16 v[204:205], v47 offset:28672
    ds_read_b64_tr_b16 v[206:207], v47 offset:32768
    v_mfma_f32_16x16x32_bf16 v[128:131], v[168:171], v[160:163], v[128:131]
    v_mfma_f32_16x16x32_bf16 v[132:135], v[168:171], v[164:167], v[132:135]
    v_mfma_f32_16x16x32_bf16 v[136:139], v[172:175], v[160:163], v[136:139]
    v_mfma_f32_16x16x32_bf16 v[140:143], v[172:175], v[164:167], v[140:143]
    s_add_u32 s39, s39, 8192
    s_cmp_ge_u32 s39, 28672
    s_cselect_b32 s30, 28672, 0
    s_sub_u32 s39, s39, s30
    s_waitcnt lgkmcnt(6)
    v_mfma_f32_16x16x32_bf16 v[128:131], v[184:187], v[176:179], v[128:131]
    v_mfma_f32_16x16x32_bf16 v[132:135], v[184:187], v[180:183], v[132:135]
    v_mfma_f32_16x16x32_bf16 v[136:139], v[188:191], v[176:179], v[136:139]
    v_mfma_f32_16x16x32_bf16 v[140:143], v[188:191], v[180:183], v[140:143]
    v_add_u32 v44, s39, v36
    v_add_u32 v45, s39, v37
    v_add_u32 v46, s39, v38
    v_add_u32 v47, s39, v39
    v_add_u32 v48, 2048, v48
    s_waitcnt lgkmcnt(0)
    v_mfma_f32_16x16x32_bf16 v[128:131], v[200:203], v[192:195], v[128:131]
    v_mfma_f32_16x16x32_bf16 v[132:135], v[200:203], v[196:199], v[132:135]
    v_mfma_f32_16x16x32_bf16 v[136:139], v[204:207], v[192:195], v[136:139]
    v_mfma_f32_16x16x32_bf16 v[140:143], v[204:207], v[196:199], v[140:143]
    s_add_u32 s37, s37, 1
    s_cmp_lt_u32 s37, s36
    s_cbranch_scc1 L_round
L_exit:
    s_cmp_lg_u32 s90, 0
    s_cbranch_scc0 L_pubslow
    s_nop 1
    v_pk_mul_f32 v[128:129], v[128:129], v[50:51] op_sel_hi:[1,0]
    v_pk_mul_f32 v[130:131], v[130:131], v[50:51] op_sel_hi:[1,0]
    v_cvt_pk_bf16_f32 v208, v128, v129
    v_cvt_pk_bf16_f32 v209, v130, v131
    v_bitop3_b32 v211, v208, v209, v224 bitop3:0x96
    buffer_store_dwordx4 v[208:211], v43, s[80:83], s94 offen offset:0
    v_pk_mul_f32 v[132:133], v[132:133], v[50:51] op_sel:[0,1] op_sel_hi:[1,1]
    v_pk_mul_f32 v[134:135], v[134:135], v[50:51] op_sel:[0,1] op_sel_hi:[1,1]
    v_cvt_pk_bf16_f32 v212, v132, v133
    v_cvt_pk_bf16_f32 v213, v134, v135
    v_bitop3_b32 v215, v212, v213, v225 bitop3:0x96
    buffer_store_dwordx4 v[212:215], v43, s[80:83], s94 offen offset:1024
    v_pk_mul_f32 v[136:137], v[136:137], v[50:51] op_sel_hi:[1,0]
    v_pk_mul_f32 v[138:139], v[138:139], v[50:51] op_sel_hi:[1,0]
    v_cvt_pk_bf16_f32 v216, v136, v137
    v_cvt_pk_bf16_f32 v217, v138, v139
    v_bitop3_b32 v219, v216, v217, v224 bitop3:0x96
    buffer_store_dwordx4 v[216:219], v43, s[80:83], s94 offen offset:2048
    v_pk_mul_f32 v[140:141], v[140:141], v[50:51] op_sel:[0,1] op_sel_hi:[1,1]
    v_pk_mul_f32 v[142:143], v[142:143], v[50:51] op_sel:[0,1] op_sel_hi:[1,1]
    v_cvt_pk_bf16_f32 v220, v140, v141
    v_cvt_pk_bf16_f32 v221, v142, v143
    v_bitop3_b32 v223, v220, v221, v225 bitop3:0x96
    buffer_store_dwordx4 v[220:223], v43, s[80:83], s94 offen offset:3072
L_pubdone:
    s_cmp_eq_u32 s24, 1
    s_cbranch_scc1 L_direct
    s_cmp_ge_u32 s26, 4
    s_cbranch_scc1 L_fin
    s_mov_b32 s32, 262144
L_poll:
    buffer_load_dwordx4 v[64:67], v43, s[80:83], s4 offen sc1
    buffer_load_dwordx4 v[68:71], v43, s[80:83], s5 offen sc1
    s_cmp_le_u32 s24, 2
    s_cbranch_scc1 L_i4
    buffer_load_dwordx4 v[72:75], v43, s[80:83], s6 offen sc1
    s_cmp_le_u32 s24, 3
    s_cbranch_scc1 L_i4
    buffer_load_dwordx4 v[76:79], v43, s[80:83], s7 offen sc1
L_i4:
    s_cmp_le_u32 s46, 4
    s_cbranch_scc1 L_i8
    buffer_load_dwordx4 v[80:83], v43, s[80:83], s8 offen sc1
    s_cmp_le_u32 s46, 5
    s_cbranch_scc1 L_i8
    buffer_load_dwordx4 v[84:87], v43, s[80:83], s9 offen sc1
    s_cmp_le_u32 s46, 6
    s_cbranch_scc1 L_i8
    buffer_load_dwordx4 v[88:91], v43, s[80:83], s10 offen sc1
    s_cmp_le_u32 s46, 7
    s_cbranch_scc1 L_i8
    buffer_load_dwordx4 v[92:95], v43, s[80:83], s11 offen sc1
L_i8:
    v_mov_b32 v236, 0
    s_waitcnt vmcnt(0)
    v_bitop3_b32 v234, v64, v65, v66 bitop3:0x96
    v_bitop3_b32 v234, v234, v67, s12 bitop3:0x96
    v_or_b32 v236, v236, v234
    v_bitop3_b32 v234, v68, v69, v70 bitop3:0x96
    v_bitop3_b32 v234, v234, v71, s13 bitop3:0x96
    v_or_b32 v236, v236, v234
    s_cmp_le_u32 s24, 2
    s_cbranch_scc1 L_c4
    v_bitop3_b32 v234, v72, v73, v74 bitop3:0x96
    v_bitop3_b32 v234, v234, v75, s14 bitop3:0x96
    v_or_b32 v236, v236, v234
    s_cmp_le_u32 s24, 3
    s_cbranch_scc1 L_c4
    v_bitop3_b32 v234, v76, v77, v78 bitop3:0x96
    v_bitop3_b32 v234, v234, v79, s15 bitop3:0x96
    v_or_b32 v236, v236, v234
L_c4:
    s_cmp_le_u32 s46, 4
    s_cbranch_scc1 L_c8
    v_bitop3_b32 v234, v80, v81, v82 bitop3:0x96
    v_bitop3_b32 v234, v234, v83, s16 bitop3:0x96
    v_or_b32 v236, v236, v234
    s_cmp_le_u32 s46, 5
    s_cbranch_scc1 L_c8
    v_bitop3_b32 v234, v84, v85, v86 bitop3:0x96
    v_bitop3_b32 v234, v234, v87, s17 bitop3:0x96
    v_or_b32 v236, v236, v234
    s_cmp_le_u32 s46, 6
    s_cbranch_scc1 L_c8
    v_bitop3_b32 v234, v88, v89, v90 bitop3:0x96
    v_bitop3_b32 v234, v234, v91, s18 bitop3:0x96
    v_or_b32 v236, v236, v234
    s_cmp_le_u32 s46, 7
    s_cbranch_scc1 L_c8
    v_bitop3_b32 v234, v92, v93, v94 bitop3:0x96
    v_bitop3_b32 v234, v234, v95, s19 bitop3:0x96
    v_or_b32 v236, v236, v234
L_c8:
    v_cmp_eq_u32 vcc, 0, v236
    s_sub_u32 s32, s32, 1
    s_cbranch_scc1 L_ok
    s_cmp_eq_u64 vcc, exec
    s_cbranch_scc0 L_poll
L_ok:
    s_cmp_lg_u32 s1, 0
    s_cbranch_scc1 L_fix
L_merge:
    v_max3_f32 v232, v66, v70, v74
    s_cmp_lg_u32 s41, 0
    v_max_f32 v232, v232, v78
    s_cbranch_scc1 L_mx
    v_max3_f32 v232, v232, v82, v86
    v_max3_f32 v232, v232, v90, v94
L_mx:
    v_sub_f32 v66, v66, v232
    v_exp_f32 v66, v66
    v_lshlrev_b32 v234, 16, v64
    v_and_b32 v235, s47, v64
    v_lshlrev_b32 v236, 16, v65
    v_and_b32 v237, s47, v65
    v_mov_b32 v233, v66
    v_pk_mul_f32 v[228:229], v[234:235], v[66:67] op_sel_hi:[1,0]
    v_pk_mul_f32 v[230:231], v[236:237], v[66:67] op_sel_hi:[1,0]
L_acc1:
    s_cmp_le_u32 s45, 1
    s_cbranch_scc1 L_mg
    v_sub_f32 v70, v70, v232
    v_exp_f32 v70, v70
    v_lshlrev_b32 v234, 16, v68
    v_and_b32 v235, s47, v68
    v_lshlrev_b32 v236, 16, v69
    v_and_b32 v237, s47, v69
    v_add_f32 v233, v233, v70
    v_pk_fma_f32 v[228:229], v[234:235], v[70:71], v[228:229] op_sel_hi:[1,0,1]
    v_pk_fma_f32 v[230:231], v[236:237], v[70:71], v[230:231] op_sel_hi:[1,0,1]
    s_cmp_le_u32 s45, 2
    s_cbranch_scc1 L_mg
    v_sub_f32 v74, v74, v232
    v_exp_f32 v74, v74
    v_lshlrev_b32 v234, 16, v72
    v_and_b32 v235, s47, v72
    v_lshlrev_b32 v236, 16, v73
    v_and_b32 v237, s47, v73
    v_add_f32 v233, v233, v74
    v_pk_fma_f32 v[228:229], v[234:235], v[74:75], v[228:229] op_sel_hi:[1,0,1]
    v_pk_fma_f32 v[230:231], v[236:237], v[74:75], v[230:231] op_sel_hi:[1,0,1]
    s_cmp_le_u32 s45, 3
    s_cbranch_scc1 L_mg
    v_sub_f32 v78, v78, v232
    v_exp_f32 v78, v78
    v_lshlrev_b32 v234, 16, v76
    v_and_b32 v235, s47, v76
    v_lshlrev_b32 v236, 16, v77
    v_and_b32 v237, s47, v77
    v_add_f32 v233, v233, v78
    v_pk_fma_f32 v[228:229], v[234:235], v[78:79], v[228:229] op_sel_hi:[1,0,1]
    v_pk_fma_f32 v[230:231], v[236:237], v[78:79], v[230:231] op_sel_hi:[1,0,1]
    s_cmp_le_u32 s45, 4
    s_cbranch_scc1 L_mg
    v_sub_f32 v82, v82, v232
    v_exp_f32 v82, v82
    v_lshlrev_b32 v234, 16, v80
    v_and_b32 v235, s47, v80
    v_lshlrev_b32 v236, 16, v81
    v_and_b32 v237, s47, v81
    v_add_f32 v233, v233, v82
    v_pk_fma_f32 v[228:229], v[234:235], v[82:83], v[228:229] op_sel_hi:[1,0,1]
    v_pk_fma_f32 v[230:231], v[236:237], v[82:83], v[230:231] op_sel_hi:[1,0,1]
    s_cmp_le_u32 s45, 5
    s_cbranch_scc1 L_mg
    v_sub_f32 v86, v86, v232
    v_exp_f32 v86, v86
    v_lshlrev_b32 v234, 16, v84
    v_and_b32 v235, s47, v84
    v_lshlrev_b32 v236, 16, v85
    v_and_b32 v237, s47, v85
    v_add_f32 v233, v233, v86
    v_pk_fma_f32 v[228:229], v[234:235], v[86:87], v[228:229] op_sel_hi:[1,0,1]
    v_pk_fma_f32 v[230:231], v[236:237], v[86:87], v[230:231] op_sel_hi:[1,0,1]
    s_cmp_le_u32 s45, 6
    s_cbranch_scc1 L_mg
    v_sub_f32 v90, v90, v232
    v_exp_f32 v90, v90
    v_lshlrev_b32 v234, 16, v88
    v_and_b32 v235, s47, v88
    v_lshlrev_b32 v236, 16, v89
    v_and_b32 v237, s47, v89
    v_add_f32 v233, v233, v90
    v_pk_fma_f32 v[228:229], v[234:235], v[90:91], v[228:229] op_sel_hi:[1,0,1]
    v_pk_fma_f32 v[230:231], v[236:237], v[90:91], v[230:231] op_sel_hi:[1,0,1]
    s_cmp_le_u32 s45, 7
    s_cbranch_scc1 L_mg
    v_sub_f32 v94, v94, v232
    v_exp_f32 v94, v94
    v_lshlrev_b32 v234, 16, v92
    v_and_b32 v235, s47, v92
    v_lshlrev_b32 v236, 16, v93
    v_and_b32 v237, s47, v93
    v_add_f32 v233, v233, v94
    v_pk_fma_f32 v[228:229], v[234:235], v[94:95], v[228:229] op_sel_hi:[1,0,1]
    v_pk_fma_f32 v[230:231], v[236:237], v[94:95], v[230:231] op_sel_hi:[1,0,1]
L_mg:
    s_cmp_gt_u32 s44, 8
    s_cbranch_scc1 L_more
    v_rcp_f32 v233, v233
    s_cmp_lg_u32 s41, 0
    v_pk_mul_f32 v[228:229], v[228:229], v[232:233] op_sel:[0,1] op_sel_hi:[1,1]
    v_pk_mul_f32 v[230:231], v[230:231], v[232:233] op_sel:[0,1] op_sel_hi:[1,1]
    v_cvt_pk_bf16_f32 v228, v228, v229
    v_cvt_pk_bf16_f32 v229, v230, v231
    buffer_store_dwordx2 v[228:229], v226, s[72:75], s42 offen
    s_cbranch_scc0 L_fin
    v_mov_b32 v64, v80
    v_mov_b32 v65, v81
    v_mov_b32 v66, v82
    v_mov_b32 v67, v83
    v_mov_b32 v68, v84
    v_mov_b32 v69, v85
    v_mov_b32 v70, v86
    v_mov_b32 v71, v87
    v_mov_b32 v72, v88
    v_mov_b32 v73, v89
    v_mov_b32 v74, v90
    v_mov_b32 v75, v91
    s_mov_b32 s42, s43
    s_mov_b32 s41, 0
    v_mov_b32 v82, v20
    v_mov_b32 v86, v20
    v_mov_b32 v90, v20
    v_mov_b32 v94, v20
    s_branch L_merge
L_fix:
    s_cmp_gt_u32 s45, 1
    s_cbranch_scc1 L_fx1
    v_mov_b32 v70, v20
L_fx1:
    s_cmp_gt_u32 s45, 2
    s_cbranch_scc1 L_fx2
    v_mov_b32 v74, v20
L_fx2:
    s_cmp_gt_u32 s45, 3
    s_cbranch_scc1 L_fx3
    v_mov_b32 v78, v20
L_fx3:
    s_cmp_gt_u32 s45, 4
    s_cbranch_scc1 L_fx4
    v_mov_b32 v82, v20
L_fx4:
    s_cmp_gt_u32 s45, 5
    s_cbranch_scc1 L_fx5
    v_mov_b32 v86, v20
L_fx5:
    s_cmp_gt_u32 s45, 6
    s_cbranch_scc1 L_fx6
    v_mov_b32 v90, v20
L_fx6:
    s_cmp_gt_u32 s45, 7
    s_cbranch_scc1 L_fx7
    v_mov_b32 v94, v20
L_fx7:
    v_max3_f32 v234, v232, v66, v70
    v_max3_f32 v234, v234, v74, v78
    v_max3_f32 v234, v234, v82, v86
    v_max3_f32 v234, v234, v90, v94
    v_sub_f32 v235, v232, v234
    v_exp_f32 v235, v235
    v_mov_b32 v232, v234
    v_mul_f32 v233, v233, v235
    v_mul_f32 v228, v228, v235
    v_mul_f32 v229, v229, v235
    v_mul_f32 v230, v230, v235
    v_mul_f32 v231, v231, v235
    v_sub_f32 v66, v66, v232
    v_exp_f32 v66, v66
    v_lshlrev_b32 v234, 16, v64
    v_and_b32 v235, s47, v64
    v_lshlrev_b32 v236, 16, v65
    v_and_b32 v237, s47, v65
    v_add_f32 v233, v233, v66
    v_pk_fma_f32 v[228:229], v[234:235], v[66:67], v[228:229] op_sel_hi:[1,0,1]
    v_pk_fma_f32 v[230:231], v[236:237], v[66:67], v[230:231] op_sel_hi:[1,0,1]
    s_branch L_acc1
L_pubslow:
    s_nop 1
    v_pk_mul_f32 v[128:129], v[128:129], v[50:51] op_sel_hi:[1,0]
    v_pk_mul_f32 v[130:131], v[130:131], v[50:51] op_sel_hi:[1,0]
    v_cvt_pk_bf16_f32 v208, v128, v129
    v_cvt_pk_bf16_f32 v209, v130, v131
    v_bitop3_b32 v211, v208, v209, v224 bitop3:0x96
    buffer_store_dwordx4 v[208:211], v43, s[80:83], s94 offen offset:0 sc1
    v_pk_mul_f32 v[132:133], v[132:133], v[50:51] op_sel:[0,1] op_sel_hi:[1,1]
    v_pk_mul_f32 v[134:135], v[134:135], v[50:51] op_sel:[0,1] op_sel_hi:[1,1]
    v_cvt_pk_bf16_f32 v212, v132, v133
    v_cvt_pk_bf16_f32 v213, v134, v135
    v_bitop3_b32 v215, v212, v213, v225 bitop3:0x96
    buffer_store_dwordx4 v[212:215], v43, s[80:83], s94 offen offset:1024 sc1
    v_pk_mul_f32 v[136:137], v[136:137], v[50:51] op_sel_hi:[1,0]
    v_pk_mul_f32 v[138:139], v[138:139], v[50:51] op_sel_hi:[1,0]
    v_cvt_pk_bf16_f32 v216, v136, v137
    v_cvt_pk_bf16_f32 v217, v138, v139
    v_bitop3_b32 v219, v216, v217, v224 bitop3:0x96
    buffer_store_dwordx4 v[216:219], v43, s[80:83], s94 offen offset:2048 sc1
    v_pk_mul_f32 v[140:141], v[140:141], v[50:51] op_sel:[0,1] op_sel_hi:[1,1]
    v_pk_mul_f32 v[142:143], v[142:143], v[50:51] op_sel:[0,1] op_sel_hi:[1,1]
    v_cvt_pk_bf16_f32 v220, v140, v141
    v_cvt_pk_bf16_f32 v221, v142, v143
    v_bitop3_b32 v223, v220, v221, v225 bitop3:0x96
    buffer_store_dwordx4 v[220:223], v43, s[80:83], s94 offen offset:3072 sc1
    s_branch L_pubdone
L_more:
    s_sub_u32 s44, s44, 8
    s_min_u32 s45, s44, 8
    s_mov_b32 s46, s44
    s_mov_b32 s1, 1
    s_add_u32 s30, s40, 131072
    s_cmp_gt_u32 s44, 0
    s_cselect_b32 s4, s30, 0x80000000
    s_cselect_b32 s12, s93, 0
    s_add_u32 s30, s40, 147456
    s_cmp_gt_u32 s44, 1
    s_cselect_b32 s5, s30, 0x80000000
    s_cselect_b32 s13, s93, 0
    s_add_u32 s30, s40, 163840
    s_cmp_gt_u32 s44, 2
    s_cselect_b32 s6, s30, 0x80000000
    s_cselect_b32 s14, s93, 0
    s_add_u32 s30, s40, 180224
    s_cmp_gt_u32 s44, 3
    s_cselect_b32 s7, s30, 0x80000000
    s_cselect_b32 s15, s93, 0
    s_add_u32 s30, s40, 196608
    s_cmp_gt_u32 s44, 4
    s_cselect_b32 s8, s30, 0x80000000
    s_cselect_b32 s16, s93, 0
    s_add_u32 s30, s40, 212992
    s_cmp_gt_u32 s44, 5
    s_cselect_b32 s9, s30, 0x80000000
    s_cselect_b32 s17, s93, 0
    s_add_u32 s30, s40, 229376
    s_cmp_gt_u32 s44, 6
    s_cselect_b32 s10, s30, 0x80000000
    s_cselect_b32 s18, s93, 0
    s_add_u32 s30, s40, 245760
    s_cmp_gt_u32 s44, 7
    s_cselect_b32 s11, s30, 0x80000000
    s_cselect_b32 s19, s93, 0
    s_add_u32 s40, s40, 131072
    s_mov_b32 s32, 262144
    s_branch L_poll
L_direct:
    s_lshl_b32 s30, s20, 6
    s_add_u32 s30, s30, 0
    buffer_store_dwordx2 v[208:209], v226, s[72:75], s30 offen
    s_lshl_b32 s30, s20, 6
    s_add_u32 s30, s30, 4096
    buffer_store_dwordx2 v[212:213], v226, s[72:75], s30 offen
    s_lshl_b32 s30, s20, 6
    s_add_u32 s30, s30, 32
    buffer_store_dwordx2 v[216:217], v226, s[72:75], s30 offen
    s_lshl_b32 s30, s20, 6
    s_add_u32 s30, s30, 4128
    buffer_store_dwordx2 v[220:221], v226, s[72:75], s30 offen
L_fin:
L_end:
    s_endpgm
.section .rodata,"a"
.p2align 6
.amdhsa_kernel standalone__paged_block_table_kv_pagedattention__sampling_kernel
  .amdhsa_next_free_vgpr 324
  .amdhsa_next_free_sgpr 102
  .amdhsa_accum_offset 256
  .amdhsa_group_segment_fixed_size 0
  .amdhsa_kernarg_size 64
  .amdhsa_user_sgpr_count 2
  .amdhsa_user_sgpr_kernarg_segment_ptr 1
  .amdhsa_system_sgpr_workgroup_id_x 1
.end_amdhsa_kernel
```
